```python
import torch

def _softmax(x, axis=-1):
    return torch.softmax(x, dim=axis)
def _gelu(x):
    return torch.nn.functional.gelu(x, approximate="tanh")
def _silu(x):
    return torch.nn.functional.silu(x)
def _sigmoid(x):
    return torch.sigmoid(x)
def _layernorm(x, axis=-1, eps=1e-5):
    m = x.mean(dim=axis, keepdim=True)
    v = x.var(dim=axis, keepdim=True, unbiased=False)
    return (x - m) / torch.sqrt(v + eps)
def _scatter_add(tgt, idx, src, axis=0):
    return tgt.clone().index_add_(axis, idx, src)
def _segment_sum(src, seg, n):
    out = torch.zeros((n,) + src.shape[1:], dtype=src.dtype)
    return out.index_add_(0, seg, src)
def _pad(x, pw):
    flat = tuple(v for pair in reversed(pw) for v in pair)
    return torch.nn.functional.pad(x, flat)

kernel_name = 'concat_heads__sliding_block_cached__sliding_block_cached__decode'

def setup_inputs():

    _w = (lambda a: (lambda t: t.to(torch.bfloat16) if t.is_floating_point() else t)(torch.as_tensor(a)))
    def _A_setup():
        B, Sq, D = 1, 1, 640
        Hq, Hkv, Sk, Dh = 32, 32, 8192, 192
        assert Hq % Hkv == 0, (Hq, Hkv)
        return {
            "x": _w((lambda *s: torch.randn(*s, dtype=torch.bfloat16) * 0.8)(B, Sq, D)),
            "k_cache": _w((lambda *s: torch.randn(*s, dtype=torch.bfloat16) * 0.8)(B, Hkv, Sk, Dh)),
            "v_cache": _w((lambda *s: torch.randn(*s, dtype=torch.bfloat16) * 0.05)(B, Hkv, Sk, Dh)),
            "wq": _w((lambda *s: torch.randn(*s, dtype=torch.bfloat16) * 0.8)(D, Hq * Dh) * (D ** -0.5)),
            "wo": _w((lambda *s: torch.randn(*s, dtype=torch.bfloat16) * 0.05)(Hq * Dh, D) * ((Hq * Dh) ** -0.5)),
        }
    _A_in = _A_setup()

    def _B_setup():
        B, Sq, D = 1, 1, 640
        Hq, Hkv, Sk, Dh = 32, 32, 8192, 192
        assert Hq % Hkv == 0, (Hq, Hkv)
        return {
            "x": _w((lambda *s: torch.randn(*s, dtype=torch.bfloat16) * 0.8)(B, Sq, D)),
            "k_cache": _w((lambda *s: torch.randn(*s, dtype=torch.bfloat16) * 0.8)(B, Hkv, Sk, Dh)),
            "v_cache": _w((lambda *s: torch.randn(*s, dtype=torch.bfloat16) * 0.05)(B, Hkv, Sk, Dh)),
            "wq": _w((lambda *s: torch.randn(*s, dtype=torch.bfloat16) * 0.8)(D, Hq * Dh) * (D ** -0.5)),
            "wo": _w((lambda *s: torch.randn(*s, dtype=torch.bfloat16) * 0.05)(Hq * Dh, D) * ((Hq * Dh) ** -0.5)),
        }
    _B_in = _B_setup()

    return {
        "A_x": _A_in["x"],
        "A_k_cache": _A_in["k_cache"],
        "A_v_cache": _A_in["v_cache"],
        "A_wq": _A_in["wq"],
        "A_wo": _A_in["wo"],
        "B_x": _B_in["x"],
        "B_k_cache": _B_in["k_cache"],
        "B_v_cache": _B_in["v_cache"],
        "B_wq": _B_in["wq"],
        "B_wo": _B_in["wo"],
    }

def reference(A_x, A_k_cache, A_v_cache, A_wq, A_wo, B_x, B_k_cache, B_v_cache, B_wq, B_wo):
    def _A_ref(x, k_cache, v_cache, wq, wo):
        B, Sq, D = x.shape
        Hq, Dh = 32, 192
        Hkv, Sk = k_cache.shape[1], k_cache.shape[2]
        W = min(4096, max(256, Sk // 4))
        rep = Hq // Hkv
        q = (lambda x, *d: x.permute(*d))((x @ wq).reshape(B, Sq, Hq, Dh), 0, 2, 1, 3)
        k = (lambda x, n, axis: torch.repeat_interleave(x, n, dim=axis))(k_cache[:, :, Sk - W:, :], rep, axis=1)
        v = (lambda x, n, axis: torch.repeat_interleave(x, n, dim=axis))(v_cache[:, :, Sk - W:, :], rep, axis=1)
        scores = torch.einsum("bhqd,bhkd->bhqk", q, k) * (Dh ** -0.5)
        p = _softmax(scores, axis=-1)
        o = torch.einsum("bhqk,bhkd->bhqd", p, v)
        return (lambda x, *d: x.permute(*d))(o, 0, 2, 1, 3).reshape(B, Sq, Hq * Dh) @ wo

    def _B_ref(x, k_cache, v_cache, wq, wo):
        B, Sq, D = x.shape
        Hq, Dh = 32, 192
        Hkv, Sk = k_cache.shape[1], k_cache.shape[2]
        W = min(4096, max(256, Sk // 4))
        rep = Hq // Hkv
        q = (lambda x, *d: x.permute(*d))((x @ wq).reshape(B, Sq, Hq, Dh), 0, 2, 1, 3)
        k = (lambda x, n, axis: torch.repeat_interleave(x, n, dim=axis))(k_cache[:, :, Sk - W:, :], rep, axis=1)
        v = (lambda x, n, axis: torch.repeat_interleave(x, n, dim=axis))(v_cache[:, :, Sk - W:, :], rep, axis=1)
        scores = torch.einsum("bhqd,bhkd->bhqk", q, k) * (Dh ** -0.5)
        p = _softmax(scores, axis=-1)
        o = torch.einsum("bhqk,bhkd->bhqd", p, v)
        return (lambda x, *d: x.permute(*d))(o, 0, 2, 1, 3).reshape(B, Sq, Hq * Dh) @ wo

    a = _A_ref(A_x, A_k_cache, A_v_cache, A_wq, A_wo)
    b = _B_ref(B_x, B_k_cache, B_v_cache, B_wq, B_wo)
    return torch.concatenate([a, b], axis=-1)
```

```asm
; @launch grid=(256,1,1) block=(768,1,1) lds=29696
.amdgcn_target "amdgcn-amd-amdhsa--gfx950"
.text
.globl concat_heads__sliding_block_cached__sliding_block_cached__decode_kernel
.p2align 8
.type concat_heads__sliding_block_cached__sliding_block_cached__decode_kernel,@function
concat_heads__sliding_block_cached__sliding_block_cached__decode_kernel:
    s_cmp_ge_u32 s2, 256
    s_cbranch_scc1 L_end
    s_lshr_b32 s6, s2, 7
    s_mul_i32 s3, s6, 40
    s_add_u32 s20, s0, s3
    s_addc_u32 s21, s1, 0
    s_load_dwordx8 s[8:15], s[20:21], 0
    s_load_dwordx2 s[16:17], s[20:21], 32
    s_load_dwordx2 s[24:25], s[0:1], 80
    s_load_dwordx2 s[28:29], s[0:1], 96
    v_lshrrev_b32 v1, 6, v0
    s_and_b32 s3, s2, 7
    s_lshr_b32 s4, s2, 5
    s_lshl_b32 s4, s4, 3
    s_add_u32 s4, s4, s3
    s_lshr_b32 s5, s2, 3
    s_and_b32 s5, s5, 3
    v_readfirstlane_b32 s18, v1
    s_and_b32 s7, s4, 31
    v_and_b32 v0, 63, v0
    v_lshrrev_b32 v10, 3, v0
    v_and_b32 v11, 7, v0
    s_lshl_b32 s3, s6, 7
    s_cmp_lt_u32 s18, 4
    s_cbranch_scc0 L_kvwave
    s_setprio 3
    v_mul_u32_u24 v1, 61440, v10
    v_lshl_add_u32 v1, v11, 4, v1
    v_mul_u32_u24 v9, 10, v10
    s_mul_i32 s22, s7, 384
    s_mul_i32 s23, s5, 1966080
    s_add_u32 s22, s22, s23
    s_mul_i32 s36, s5, 320
    s_mul_i32 s23, s18, 80
    s_add_u32 s36, s36, s23
    s_mul_i32 s37, s18, 491520
    s_mov_b32 s62, 1954176
    s_mov_b32 s63, 0x20000
    s_mov_b32 s50, 1280
    s_mov_b32 s51, 0x20000
    s_waitcnt lgkmcnt(0)
    s_add_u32 s60, s14, s22
    s_addc_u32 s61, s15, 0
    s_mov_b32 s48, s8
    s_mov_b32 s49, s9
    buffer_load_dwordx4 v[40:43], v1, s[60:63], s37 offen offset:0 nt
    buffer_load_dwordx4 v[44:47], v1, s[60:63], s37 offen offset:128 nt
    buffer_load_dwordx4 v[48:51], v1, s[60:63], s37 offen offset:256 nt
    s_add_u32 s37, s37, 12288
    buffer_load_ushort v4, v9, s[48:51], s36 offen offset:0
    buffer_load_ushort v5, v9, s[48:51], s36 offen offset:2
    buffer_load_ushort v6, v9, s[48:51], s36 offen offset:4
    buffer_load_ushort v7, v9, s[48:51], s36 offen offset:6
    buffer_load_ushort v8, v9, s[48:51], s36 offen offset:8
    buffer_load_dwordx4 v[52:55], v1, s[60:63], s37 offen offset:0 nt
    buffer_load_dwordx4 v[56:59], v1, s[60:63], s37 offen offset:128 nt
    buffer_load_dwordx4 v[60:63], v1, s[60:63], s37 offen offset:256 nt
    s_add_u32 s37, s37, 12288
    buffer_load_dwordx4 v[64:67], v1, s[60:63], s37 offen offset:0 nt
    buffer_load_dwordx4 v[68:71], v1, s[60:63], s37 offen offset:128 nt
    buffer_load_dwordx4 v[72:75], v1, s[60:63], s37 offen offset:256 nt
    s_add_u32 s37, s37, 12288
    buffer_load_dwordx4 v[76:79], v1, s[60:63], s37 offen offset:0 nt
    buffer_load_dwordx4 v[80:83], v1, s[60:63], s37 offen offset:128 nt
    buffer_load_dwordx4 v[84:87], v1, s[60:63], s37 offen offset:256 nt
    s_add_u32 s37, s37, 12288
    buffer_load_dwordx4 v[88:91], v1, s[60:63], s37 offen offset:0 nt
    buffer_load_dwordx4 v[92:95], v1, s[60:63], s37 offen offset:128 nt
    buffer_load_dwordx4 v[96:99], v1, s[60:63], s37 offen offset:256 nt
    s_load_dword s42, s[28:29], s3
    s_barrier
    s_mov_b32 s19, 0x3dd53b95
    s_mov_b32 s34, 0x00ff00ff
    s_mov_b32 s35, 0xff00ff00
    s_mov_b32 s68, s28
    s_mov_b32 s69, s29
    s_mov_b32 s70, 528384
    s_mov_b32 s71, 0x20000
    s_mul_i32 s22, s7, 192
    s_and_b32 s23, s5, 1
    s_mul_i32 s23, s23, 96
    s_add_u32 s22, s22, s23
    s_mul_i32 s22, s22, 1280
    s_lshr_b32 s23, s5, 1
    s_mul_i32 s23, s23, 640
    s_add_u32 s22, s22, s23
    s_add_u32 s64, s16, s22
    s_addc_u32 s65, s17, 0
    s_mov_b32 s66, 122240
    s_mov_b32 s67, 0x20000
    s_mov_b32 s76, s24
    s_mov_b32 s77, s25
    s_mov_b32 s78, 2560
    s_mov_b32 s79, 0x20000
    v_and_b32 v28, 1, v0
    v_lshlrev_b32 v28, 4, v28
    v_mov_b32 v29, 0xffff
    v_lshlrev_b32 v28, v28, v29
    s_mov_b32 s20, 0x03030303
    s_mov_b32 s21, 0x03030303
    v_cndmask_b32 v36, 0, v28, s[20:21]
    s_lshl_b64 s[20:21], s[20:21], 2
    v_cndmask_b32 v37, 0, v28, s[20:21]
    s_lshl_b64 s[20:21], s[20:21], 2
    v_cndmask_b32 v38, 0, v28, s[20:21]
    s_lshl_b64 s[20:21], s[20:21], 2
    v_cndmask_b32 v39, 0, v28, s[20:21]
    v_lshlrev_b32 v3, 5, v11
    v_bfe_u32 v28, v0, 4, 1
    v_lshl_add_u32 v3, v28, 4, v3
    v_lshrrev_b32 v28, 5, v0
    s_lshl_b32 s30, s18, 1
    v_add_u32 v28, s30, v28
    v_mul_u32_u24 v2, 1280, v28
    v_mul_u32_u24 v28, 768, v28
    v_add_u32 v2, v3, v2
    v_add_u32 v3, v3, v28
    s_waitcnt vmcnt(12)
    v_lshl_or_b32 v28, v4, 16, v4
    v_and_b32 v12, v36, v28
    v_and_b32 v13, v37, v28
    v_and_b32 v14, v38, v28
    v_and_b32 v15, v39, v28
    s_nop 1
    v_mfma_f32_16x16x32_bf16 v[16:19], v[12:15], v[40:43], 0
    v_mfma_f32_16x16x32_bf16 v[20:23], v[12:15], v[44:47], 0
    v_mfma_f32_16x16x32_bf16 v[24:27], v[12:15], v[48:51], 0
    s_waitcnt vmcnt(9)
    v_lshl_or_b32 v28, v5, 16, v5
    v_and_b32 v12, v36, v28
    v_and_b32 v13, v37, v28
    v_and_b32 v14, v38, v28
    v_and_b32 v15, v39, v28
    s_nop 1
    v_mfma_f32_16x16x32_bf16 v[16:19], v[12:15], v[52:55], v[16:19]
    v_mfma_f32_16x16x32_bf16 v[20:23], v[12:15], v[56:59], v[20:23]
    v_mfma_f32_16x16x32_bf16 v[24:27], v[12:15], v[60:63], v[24:27]
    s_waitcnt vmcnt(6)
    v_lshl_or_b32 v28, v6, 16, v6
    v_and_b32 v12, v36, v28
    v_and_b32 v13, v37, v28
    v_and_b32 v14, v38, v28
    v_and_b32 v15, v39, v28
    s_nop 1
    v_mfma_f32_16x16x32_bf16 v[16:19], v[12:15], v[64:67], v[16:19]
    v_mfma_f32_16x16x32_bf16 v[20:23], v[12:15], v[68:71], v[20:23]
    v_mfma_f32_16x16x32_bf16 v[24:27], v[12:15], v[72:75], v[24:27]
    s_waitcnt vmcnt(3)
    v_lshl_or_b32 v28, v7, 16, v7
    v_and_b32 v12, v36, v28
    v_and_b32 v13, v37, v28
    v_and_b32 v14, v38, v28
    v_and_b32 v15, v39, v28
    s_nop 1
    v_mfma_f32_16x16x32_bf16 v[16:19], v[12:15], v[76:79], v[16:19]
    v_mfma_f32_16x16x32_bf16 v[20:23], v[12:15], v[80:83], v[20:23]
    v_mfma_f32_16x16x32_bf16 v[24:27], v[12:15], v[84:87], v[24:27]
    s_waitcnt vmcnt(0)
    v_lshl_or_b32 v28, v8, 16, v8
    v_and_b32 v12, v36, v28
    v_and_b32 v13, v37, v28
    v_and_b32 v14, v38, v28
    v_and_b32 v15, v39, v28
    s_nop 1
    v_mfma_f32_16x16x32_bf16 v[16:19], v[12:15], v[88:91], v[16:19]
    v_mfma_f32_16x16x32_bf16 v[20:23], v[12:15], v[92:95], v[20:23]
    v_mfma_f32_16x16x32_bf16 v[24:27], v[12:15], v[96:99], v[24:27]
    s_waitcnt lgkmcnt(0)
    s_nop 5
    s_mov_b64 exec, s[34:35]
    ds_write_b128 v3, v[16:19] offset:1024
    ds_write_b128 v3, v[20:23] offset:1280
    ds_write_b128 v3, v[24:27] offset:1536
    s_mov_b64 exec, -1
    v_mov_b32 v148, 0
    v_mov_b32 v105, 1
    s_mov_b64 exec, 1
    ds_add_rtn_u32 v106, v148, v105 offset:0
    s_mov_b64 exec, -1
    v_lshrrev_b32 v100, 2, v0
    v_mul_u32_u24 v100, 24, v100
    v_and_b32 v101, 3, v0
    v_min_u32 v102, 2, v101
    v_lshl_add_u32 v100, v102, 3, v100
    v_lshlrev_b32 v103, 2, v0
    s_waitcnt lgkmcnt(0)
    v_readfirstlane_b32 s30, v106
    s_mul_i32 s41, s42, 0x9e3779b1
    s_add_u32 s41, s41, 0x7f4a7c15
    s_and_b32 s41, s41, 0xbfffbfff
    s_xor_b32 s20, s41, 0x100
    s_xor_b32 s21, s41, s42
    s_cmp_lt_u32 s21, 16
    s_cselect_b32 s41, s20, s41
    v_mov_b32 v107, s41
    s_mov_b32 s20, 0x88888888
    s_mov_b32 s21, 0x88888888
    s_cmp_lg_u32 s30, 3
    s_cbranch_scc1 L_w_qdone
    ds_read_b64 v[40:41], v100 offset:1024
    ds_read_b64 v[42:43], v100 offset:1792
    ds_read_b64 v[44:45], v100 offset:2560
    ds_read_b64 v[46:47], v100 offset:3328
    ds_read_b64 v[48:49], v100 offset:4096
    ds_read_b64 v[50:51], v100 offset:4864
    ds_read_b64 v[52:53], v100 offset:5632
    ds_read_b64 v[54:55], v100 offset:6400
    ds_read_b64 v[56:57], v100 offset:1408
    ds_read_b64 v[58:59], v100 offset:2176
    ds_read_b64 v[60:61], v100 offset:2944
    ds_read_b64 v[62:63], v100 offset:3712
    ds_read_b64 v[64:65], v100 offset:4480
    ds_read_b64 v[66:67], v100 offset:5248
    s_waitcnt lgkmcnt(12)
    ds_read_b64 v[68:69], v100 offset:6016
    ds_read_b64 v[70:71], v100 offset:6784
    s_waitcnt lgkmcnt(0)
    v_add_f32 v40, v40, v42
    v_add_f32 v41, v41, v43
    v_add_f32 v44, v44, v46
    v_add_f32 v45, v45, v47
    v_add_f32 v48, v48, v50
    v_add_f32 v49, v49, v51
    v_add_f32 v52, v52, v54
    v_add_f32 v53, v53, v55
    v_add_f32 v56, v56, v58
    v_add_f32 v57, v57, v59
    v_add_f32 v60, v60, v62
    v_add_f32 v61, v61, v63
    v_add_f32 v64, v64, v66
    v_add_f32 v65, v65, v67
    v_add_f32 v68, v68, v70
    v_add_f32 v69, v69, v71
    v_add_f32 v40, v40, v44
    v_add_f32 v41, v41, v45
    v_add_f32 v48, v48, v52
    v_add_f32 v49, v49, v53
    v_add_f32 v56, v56, v60
    v_add_f32 v57, v57, v61
    v_add_f32 v64, v64, v68
    v_add_f32 v65, v65, v69
    v_add_f32 v40, v40, v48
    v_add_f32 v41, v41, v49
    v_add_f32 v56, v56, v64
    v_add_f32 v57, v57, v65
    v_cvt_pk_bf16_f32 v40, v40, v41
    v_cvt_pk_bf16_f32 v44, v56, v57
    s_getreg_b32 s45, hwreg(HW_REG_XCC_ID, 0, 4)
    s_xor_b32 s33, s45, s41
    v_mov_b32 v43, s33
    v_mov_b32 v47, s33
    v_mov_b32_dpp v41, v40 quad_perm:[1,1,1,1] row_mask:0xf bank_mask:0xf
    v_mov_b32_dpp v42, v40 quad_perm:[2,2,2,2] row_mask:0xf bank_mask:0xf
    v_mov_b32_dpp v45, v44 quad_perm:[1,1,1,1] row_mask:0xf bank_mask:0xf
    v_mov_b32_dpp v46, v44 quad_perm:[2,2,2,2] row_mask:0xf bank_mask:0xf
    s_lshl_b32 s30, s4, 2
    s_add_u32 s30, s30, s5
    s_lshl_b32 s30, s30, 9
    s_add_u32 s30, s30, 4096
    s_and_b32 s44, s2, 7
    s_cmp_eq_u32 s44, s45
    s_cselect_b32 s44, 2, 0
    s_cbranch_scc1 L_w_qplain
    s_lshr_b64 exec, s[20:21], 3
    buffer_store_dwordx4 v[40:43], v103, s[68:71], s30 offen sc1
    buffer_store_dwordx4 v[44:47], v103, s[68:71], s30 offen offset:256 sc1
    s_mov_b64 exec, -1
    s_branch L_w_qsent
L_w_qplain:
    s_lshr_b64 exec, s[20:21], 3
    buffer_store_dwordx4 v[40:43], v103, s[68:71], s30 offen
    buffer_store_dwordx4 v[44:47], v103, s[68:71], s30 offen offset:256
    s_mov_b64 exec, -1
L_w_qsent:
    s_lshl_b32 s31, s4, 11
    s_add_u32 s31, s31, 4096
    s_mov_b32 s43, 32768
L_w_qgate:
    ds_read_b32 v109, v148 offset:8
    s_waitcnt lgkmcnt(0)
    v_readfirstlane_b32 s33, v109
    s_cmp_ge_u32 s33, 8
    s_cbranch_scc1 L_w_qgate_done
    s_sleep 4
    s_branch L_w_qgate
L_w_qgate_done:
L_w_qpoll:
    buffer_load_dword v68, v103, s[68:71], s31 offen offset:0 sc1 nt
    buffer_load_dword v69, v103, s[68:71], s31 offen offset:256 sc1 nt
    buffer_load_dword v70, v103, s[68:71], s31 offen offset:512 sc1 nt
    buffer_load_dword v71, v103, s[68:71], s31 offen offset:768 sc1 nt
    buffer_load_dword v72, v103, s[68:71], s31 offen offset:1024 sc1 nt
    buffer_load_dword v73, v103, s[68:71], s31 offen offset:1280 sc1 nt
    buffer_load_dword v74, v103, s[68:71], s31 offen offset:1536 sc1 nt
    buffer_load_dword v75, v103, s[68:71], s31 offen offset:1792 sc1 nt
    s_sub_u32 s43, s43, 1
    s_cbranch_scc1 L_w_qpoll_done
    s_waitcnt vmcnt(0)
    v_max3_u32 v56, v68, v69, v70
    v_max3_u32 v57, v71, v72, v73
    v_min3_u32 v58, v68, v69, v70
    v_min3_u32 v59, v71, v72, v73
    v_max3_u32 v56, v56, v74, v75
    v_min3_u32 v58, v58, v74, v75
    v_max_u32 v56, v56, v57
    v_min_u32 v58, v58, v59
    v_xor_b32 v57, s41, v56
    v_xor_b32 v59, s41, v58
    v_or_b32 v57, v57, v59
    v_cmp_lt_u32 vcc, 15, v57
    s_and_b64 vcc, vcc, s[20:21]
    s_cbranch_scc0 L_w_qseen
    s_sub_u32 s44, s44, 1
    s_cmp_lg_u32 s44, 0
    s_cbranch_scc1 L_w_qpoll
    s_lshr_b64 exec, s[20:21], 3
    buffer_store_dwordx4 v[40:43], v103, s[68:71], s30 offen sc1
    buffer_store_dwordx4 v[44:47], v103, s[68:71], s30 offen offset:256 sc1
    s_mov_b64 exec, -1
    s_branch L_w_qpoll
L_w_qseen:
    v_cmp_ne_u32 vcc, v56, v58
    s_and_b64 vcc, vcc, s[20:21]
    s_cbranch_scc0 L_w_qsame
    s_lshr_b64 exec, s[20:21], 3
    buffer_store_dwordx4 v[40:43], v103, s[68:71], s30 offen sc1
    buffer_store_dwordx4 v[44:47], v103, s[68:71], s30 offen offset:256 sc1
    s_mov_b64 exec, -1
    s_branch L_w_qpoll_done
L_w_qsame:
    v_mov_b32 v105, 2
L_w_qpoll_done:
    s_waitcnt vmcnt(0)
    v_and_b32 v60, 0xffff0000, v68
    v_lshlrev_b32 v44, 16, v68
    v_and_b32 v61, 0xffff0000, v69
    v_lshlrev_b32 v45, 16, v69
    v_and_b32 v62, 0xffff0000, v70
    v_lshlrev_b32 v46, 16, v70
    v_and_b32 v63, 0xffff0000, v71
    v_lshlrev_b32 v47, 16, v71
    v_and_b32 v64, 0xffff0000, v72
    v_lshlrev_b32 v48, 16, v72
    v_and_b32 v65, 0xffff0000, v73
    v_lshlrev_b32 v49, 16, v73
    v_and_b32 v66, 0xffff0000, v74
    v_lshlrev_b32 v50, 16, v74
    v_and_b32 v67, 0xffff0000, v75
    v_lshlrev_b32 v51, 16, v75
    v_add_f32 v44, v44, v46
    v_add_f32 v48, v48, v50
    v_add_f32 v45, v45, v47
    v_add_f32 v49, v49, v51
    v_add_f32 v44, v44, v48
    v_add_f32 v45, v45, v49
    v_add_f32 v60, v60, v62
    v_add_f32 v64, v64, v66
    v_add_f32 v61, v61, v63
    v_add_f32 v65, v65, v67
    v_add_f32 v60, v60, v64
    v_add_f32 v61, v61, v65
    v_cvt_pk_bf16_f32 v40, v44, v60
    v_cvt_pk_bf16_f32 v41, v45, v61
    v_lshrrev_b32 v100, 1, v100
    s_not_b64 exec, s[20:21]
    ds_write_b32 v100, v40 offset:64
    ds_write_b32 v100, v41 offset:256
    s_mov_b64 exec, 1
    ds_write_b32 v148, v105 offset:4
    s_mov_b64 exec, -1
L_w_qdone:
    v_mul_u32_u24 v1, 1280, v10
    v_lshl_add_u32 v1, v11, 4, v1
    s_mul_i32 s30, s18, 30720
    v_add_u32 v1, s30, v1
    s_mov_b32 s31, 10240
    s_mov_b32 s32, 20480
    s_mul_i32 s30, s18, 96
    v_lshl_add_u32 v104, v10, 2, s30
    s_lshl_b32 s30, s18, 4
    v_lshrrev_b32 v110, 2, v0
    v_add_u32 v110, s30, v110
    v_cmp_gt_u32 vcc, 54, v110
    v_mul_u32_u24 v110, 6, v110
    v_lshl_add_u32 v110, v101, 1, v110
    s_mov_b64 s[46:47], vcc
    v_cmp_gt_u32 vcc, 320, v110
    v_min_u32 v110, 318, v110
    v_lshlrev_b32 v132, 2, v110
    s_mov_b64 s[72:73], vcc
    s_lshr_b64 s[74:75], s[20:21], 3
    s_and_b64 s[74:75], s[74:75], s[46:47]
    s_lshr_b32 s30, s5, 1
    s_lshl_b32 s40, s6, 1
    s_add_u32 s39, s40, s30
    s_lshl_b32 s40, s39, 5
    s_add_u32 s40, s40, s7
    s_lshl_b32 s40, s40, 1
    s_and_b32 s30, s5, 1
    s_add_u32 s40, s40, s30
    s_mul_i32 s40, s40, 896
    s_lshl_b32 s30, s18, 8
    s_add_u32 s40, s40, s30
    s_add_u32 s40, s40, 299008
    s_lshr_b32 s38, s7, 1
    s_and_b32 s30, s5, 1
    s_lshl1_add_u32 s38, s30, s38
    s_add_u32 s38, s38, s18
    s_and_b32 s33, s7, 7
    s_lshr_b32 s30, s18, 1
    s_or_b32 s30, s30, s33
    s_cselect_b32 s38, 14, s38
L_w_trig:
    ds_read_b32 v109, v148 offset:8
    s_waitcnt lgkmcnt(0)
    v_readfirstlane_b32 s30, v109
    s_cmp_ge_u32 s30, 136
    s_cbranch_scc1 L_w_trig_done
    s_sleep 2
    s_branch L_w_trig
L_w_trig_done:
    s_setprio 0
    buffer_load_dwordx4 v[40:43], v1, s[64:67], 0 offen offset:0 nt
    buffer_load_dwordx4 v[44:47], v1, s[64:67], 0 offen offset:128 nt
    buffer_load_dwordx4 v[48:51], v1, s[64:67], 0 offen offset:256 nt
    buffer_load_dwordx4 v[52:55], v1, s[64:67], 0 offen offset:384 nt
    buffer_load_dwordx4 v[56:59], v1, s[64:67], 0 offen offset:512 nt
    s_waitcnt vmcnt(4)
    buffer_load_dwordx4 v[60:63], v1, s[64:67], s31 offen offset:0 nt
    s_waitcnt vmcnt(4)
    buffer_load_dwordx4 v[64:67], v1, s[64:67], s31 offen offset:128 nt
    s_waitcnt vmcnt(4)
    buffer_load_dwordx4 v[68:71], v1, s[64:67], s31 offen offset:256 nt
    s_waitcnt vmcnt(4)
    buffer_load_dwordx4 v[72:75], v1, s[64:67], s31 offen offset:384 nt
    s_waitcnt vmcnt(4)
    buffer_load_dwordx4 v[76:79], v1, s[64:67], s31 offen offset:512 nt
    s_waitcnt vmcnt(4)
    buffer_load_dwordx4 v[80:83], v1, s[64:67], s32 offen offset:0 nt
    s_waitcnt vmcnt(4)
    buffer_load_dwordx4 v[84:87], v1, s[64:67], s32 offen offset:128 nt
    s_waitcnt vmcnt(4)
    buffer_load_dwordx4 v[88:91], v1, s[64:67], s32 offen offset:256 nt
    s_waitcnt vmcnt(4)
    buffer_load_dwordx4 v[92:95], v1, s[64:67], s32 offen offset:384 nt
    s_waitcnt vmcnt(4)
    buffer_load_dwordx4 v[96:99], v1, s[64:67], s32 offen offset:512 nt
L_w_owait:
    ds_read_b32 v109, v148 offset:16
    ds_read_b32 v112, v104 offset:640
    ds_read_b32 v113, v104 offset:672
    ds_read_b32 v114, v104 offset:704
    s_waitcnt lgkmcnt(0)
    v_readfirstlane_b32 s30, v109
    s_cmp_eq_u32 s30, 0
    s_cbranch_scc1 L_w_owait
    v_and_b32 v116, v36, v112
    v_and_b32 v117, v37, v112
    v_and_b32 v118, v38, v112
    v_and_b32 v119, v39, v112
    v_and_b32 v120, v36, v113
    v_and_b32 v121, v37, v113
    v_and_b32 v122, v38, v113
    v_and_b32 v123, v39, v113
    v_and_b32 v124, v36, v114
    v_and_b32 v125, v37, v114
    v_and_b32 v126, v38, v114
    v_and_b32 v127, v39, v114
    s_waitcnt vmcnt(10)
    v_mfma_f32_16x16x32_bf16 v[16:19], v[116:119], v[40:43], 0
    v_mfma_f32_16x16x32_bf16 v[20:23], v[116:119], v[44:47], 0
    v_mfma_f32_16x16x32_bf16 v[24:27], v[116:119], v[48:51], 0
    v_mfma_f32_16x16x32_bf16 v[28:31], v[116:119], v[52:55], 0
    v_mfma_f32_16x16x32_bf16 v[32:35], v[116:119], v[56:59], 0
    s_waitcnt vmcnt(5)
    v_mfma_f32_16x16x32_bf16 v[16:19], v[120:123], v[60:63], v[16:19]
    v_mfma_f32_16x16x32_bf16 v[20:23], v[120:123], v[64:67], v[20:23]
    v_mfma_f32_16x16x32_bf16 v[24:27], v[120:123], v[68:71], v[24:27]
    v_mfma_f32_16x16x32_bf16 v[28:31], v[120:123], v[72:75], v[28:31]
    v_mfma_f32_16x16x32_bf16 v[32:35], v[120:123], v[76:79], v[32:35]
    s_waitcnt vmcnt(4)
    v_mfma_f32_16x16x32_bf16 v[16:19], v[124:127], v[80:83], v[16:19]
    s_waitcnt vmcnt(3)
    v_mfma_f32_16x16x32_bf16 v[20:23], v[124:127], v[84:87], v[20:23]
    s_waitcnt vmcnt(2)
    v_mfma_f32_16x16x32_bf16 v[24:27], v[124:127], v[88:91], v[24:27]
    s_waitcnt vmcnt(1)
    v_mfma_f32_16x16x32_bf16 v[28:31], v[124:127], v[92:95], v[28:31]
    s_waitcnt vmcnt(0)
    v_mfma_f32_16x16x32_bf16 v[32:35], v[124:127], v[96:99], v[32:35]
    s_nop 2
    s_mov_b64 exec, s[34:35]
    ds_write_b128 v2, v[16:19] offset:19456
    ds_write_b128 v2, v[20:23] offset:19712
    ds_write_b128 v2, v[24:27] offset:19968
    ds_write_b128 v2, v[28:31] offset:20224
    ds_write_b128 v2, v[32:35] offset:20480
    s_mov_b64 exec, s[46:47]
    s_waitcnt lgkmcnt(0)
    s_barrier
    ds_read_b64 v[40:41], v132 offset:19456
    ds_read_b64 v[42:43], v132 offset:20736
    ds_read_b64 v[44:45], v132 offset:22016
    ds_read_b64 v[46:47], v132 offset:23296
    ds_read_b64 v[48:49], v132 offset:24576
    ds_read_b64 v[50:51], v132 offset:25856
    ds_read_b64 v[52:53], v132 offset:27136
    ds_read_b64 v[54:55], v132 offset:28416
    v_mov_b32 v59, v107
    s_waitcnt lgkmcnt(6)
    v_add_f32 v40, v40, v42
    v_add_f32 v41, v41, v43
    s_waitcnt lgkmcnt(4)
    v_add_f32 v44, v44, v46
    v_add_f32 v45, v45, v47
    s_waitcnt lgkmcnt(2)
    v_add_f32 v48, v48, v50
    v_add_f32 v49, v49, v51
    s_waitcnt lgkmcnt(0)
    v_add_f32 v52, v52, v54
    v_add_f32 v53, v53, v55
    v_add_f32 v40, v40, v44
    v_add_f32 v41, v41, v45
    v_add_f32 v48, v48, v52
    v_add_f32 v49, v49, v53
    v_add_f32 v40, v40, v48
    v_add_f32 v41, v41, v49
    v_cvt_pk_bf16_f32 v56, v40, v41
    v_cndmask_b32 v56, 0, v56, s[72:73]
    s_cmp_ge_u32 s38, 14
    s_nop 0
    v_mov_b32_dpp v57, v56 quad_perm:[1,1,1,1] row_mask:0xf bank_mask:0xf
    v_mov_b32_dpp v58, v56 quad_perm:[2,2,2,2] row_mask:0xf bank_mask:0xf
    s_mov_b64 exec, s[74:75]
    buffer_store_dwordx4 v[56:59], v103, s[68:71], s40 offen sc1
    s_cbranch_scc1 L_w_end
    s_mov_b64 exec, -1
    v_lshrrev_b32 v104, 2, v0
    v_mul_u32_u24 v104, 896, v104
    v_lshl_add_u32 v104, v101, 4, v104
    s_mul_i32 s44, s39, 57344
    s_lshl_b32 s33, s38, 6
    s_add_u32 s44, s44, s33
    s_add_u32 s44, s44, 299008
    s_add_u32 s45, s44, 14336
    s_add_u32 s46, s44, 28672
    s_add_u32 s47, s44, 43008
    s_mov_b32 s43, 32768
    s_mul_i32 s33, s38, 24
    v_mul_u32_u24 v105, 6, v101
    v_add_u32 v105, s33, v105
    v_cmp_gt_u32 vcc, 320, v105
    v_bfe_u32 v106, v0, 4, 1
    v_lshl_add_u32 v106, v106, 2, v105
    s_mov_b64 s[72:73], vcc
    v_cmp_gt_u32 vcc, 320, v106
    s_mov_b32 s20, 0x000f000f
    s_mov_b32 s21, 0
    v_lshlrev_b32 v106, 1, v106
    s_and_b64 s[74:75], vcc, s[20:21]
    v_cmp_gt_u32 vcc, 318, v105
    s_mul_i32 s31, s39, 640
    v_and_b32 v12, 0x3f803f80, v36
    v_and_b32 v13, 0x3f803f80, v37
    s_and_b64 s[20:21], vcc, 15
    v_and_b32 v14, 0x3f803f80, v38
    v_and_b32 v15, 0x3f803f80, v39
    s_mov_b64 exec, s[72:73]
    buffer_load_dwordx4 v[60:63], v104, s[68:71], s44 offen sc1
    buffer_load_dwordx4 v[64:67], v104, s[68:71], s45 offen sc1
    buffer_load_dwordx4 v[68:71], v104, s[68:71], s46 offen sc1
    buffer_load_dwordx4 v[72:75], v104, s[68:71], s47 offen sc1
    s_sleep 1
L_w_fpoll:
    buffer_load_dwordx4 v[76:79], v104, s[68:71], s44 offen sc1
    buffer_load_dwordx4 v[80:83], v104, s[68:71], s45 offen sc1
    buffer_load_dwordx4 v[84:87], v104, s[68:71], s46 offen sc1
    buffer_load_dwordx4 v[88:91], v104, s[68:71], s47 offen sc1
    s_waitcnt vmcnt(4)
    v_max3_u32 v92, v63, v67, v71
    v_min3_u32 v93, v63, v67, v71
    v_max_u32 v92, v92, v75
    v_min_u32 v93, v93, v75
    v_cmp_ne_u32 vcc, s41, v92
    v_cmp_ne_u32 s[22:23], s41, v93
    s_or_b64 vcc, vcc, s[22:23]
    s_cbranch_scc0 L_w_f0
    buffer_load_dwordx4 v[60:63], v104, s[68:71], s44 offen sc1
    buffer_load_dwordx4 v[64:67], v104, s[68:71], s45 offen sc1
    buffer_load_dwordx4 v[68:71], v104, s[68:71], s46 offen sc1
    buffer_load_dwordx4 v[72:75], v104, s[68:71], s47 offen sc1
    s_waitcnt vmcnt(4)
    v_max3_u32 v92, v79, v83, v87
    v_min3_u32 v93, v79, v83, v87
    v_max_u32 v92, v92, v91
    v_min_u32 v93, v93, v91
    v_cmp_ne_u32 vcc, s41, v92
    v_cmp_ne_u32 s[22:23], s41, v93
    s_or_b64 vcc, vcc, s[22:23]
    s_cbranch_scc0 L_w_f1
    s_sub_u32 s43, s43, 1
    s_cbranch_scc0 L_w_fpoll
L_w_f1:
    s_mov_b64 exec, -1
    v_mfma_f32_16x16x32_bf16 v[16:19], v[12:15], v[76:79], 0
    v_mfma_f32_16x16x32_bf16 v[16:19], v[12:15], v[80:83], v[16:19]
    v_mfma_f32_16x16x32_bf16 v[16:19], v[12:15], v[84:87], v[16:19]
    v_mfma_f32_16x16x32_bf16 v[16:19], v[12:15], v[88:91], v[16:19]
    s_branch L_w_fsum
L_w_f0:
    s_mov_b64 exec, -1
    v_mfma_f32_16x16x32_bf16 v[16:19], v[12:15], v[60:63], 0
    v_mfma_f32_16x16x32_bf16 v[16:19], v[12:15], v[64:67], v[16:19]
    v_mfma_f32_16x16x32_bf16 v[16:19], v[12:15], v[68:71], v[16:19]
    v_mfma_f32_16x16x32_bf16 v[16:19], v[12:15], v[72:75], v[16:19]
L_w_fsum:
    s_nop 7
    v_add_f32_dpp v16, v16, v16 row_ror:4 row_mask:0xf bank_mask:0xf
    v_add_f32_dpp v17, v17, v17 row_ror:4 row_mask:0xf bank_mask:0xf
    v_add_f32_dpp v18, v18, v18 row_ror:4 row_mask:0xf bank_mask:0xf
    v_add_f32_dpp v19, v19, v19 row_ror:4 row_mask:0xf bank_mask:0xf
    v_add_f32_dpp v16, v16, v16 row_ror:8 row_mask:0xf bank_mask:0xf
    v_add_f32_dpp v17, v17, v17 row_ror:8 row_mask:0xf bank_mask:0xf
    v_add_f32_dpp v18, v18, v18 row_ror:8 row_mask:0xf bank_mask:0xf
    v_add_f32_dpp v19, v19, v19 row_ror:8 row_mask:0xf bank_mask:0xf
    v_cvt_pk_bf16_f32 v16, v16, v17
    v_cvt_pk_bf16_f32 v18, v18, v19
    s_mov_b64 exec, s[74:75]
    buffer_store_dword v16, v106, s[76:79], s31 offen
    s_mov_b64 exec, s[20:21]
    buffer_store_dword v18, v106, s[76:79], s31 offen offset:4
    s_and_b32 s30, s39, 1
    s_or_b32 s30, s30, s38
    s_cbranch_scc1 L_w_end
    s_mov_b64 exec, 1
    buffer_store_dword v107, v148, s[68:71], s3 offen
L_w_end:
L_end:
    s_endpgm
L_kvwave:
    v_mov_b32 v3, 0
    v_mov_b32 v4, 0
    v_mov_b32 v5, 0
    v_mov_b32 v6, 0
    v_mov_b32 v7, 0
    s_sub_u32 s22, s18, 4
    s_cmp_ge_u32 s22, 1
    s_cbranch_scc1 L_kv_nozero
    ds_write_b128 v3, v[4:7] offset:0
    ds_write_b32 v3, v4 offset:16
L_kv_nozero:
    v_mul_u32_u24 v1, 384, v10
    v_lshl_add_u32 v1, v11, 4, v1
    s_lshl_b32 s23, s5, 3
    s_add_u32 s23, s23, s22
    s_mul_i32 s23, s23, 3072
    v_add_u32 v1, s23, v1
    s_mul_i32 s22, s7, 3145728
    s_add_u32 s22, s22, 2359296
    s_mov_b32 s54, 786432
    s_mov_b32 s58, 786432
    s_mov_b32 s44, 98304
    s_mov_b32 s45, 196608
    s_mov_b32 s46, 294912
    s_mov_b32 s47, 393216
    s_mov_b32 s48, 491520
    s_mov_b32 s49, 589824
    s_mov_b32 s50, 688128
    s_mov_b32 s55, 0x20000
    s_mov_b32 s59, 0x20000
    s_mov_b32 s19, 0x3dd53b95
    s_mov_b32 s34, 0x00ff00ff
    s_mov_b32 s35, 0xff00ff00
    s_mov_b32 s70, 528384
    s_mov_b32 s71, 0x20000
    v_lshlrev_b32 v2, 4, v11
    v_mov_b32 v8, 0
    v_mov_b32 v9, 0
    v_mov_b32 v10, 0
    v_mov_b32 v11, 0
    v_mov_b32 v12, 1
    s_waitcnt lgkmcnt(0)
    s_load_dword s42, s[28:29], s3
    s_add_u32 s52, s10, s22
    s_addc_u32 s53, s11, 0
    s_add_u32 s56, s12, s22
    s_addc_u32 s57, s13, 0
    s_mov_b32 s68, s28
    s_mov_b32 s69, s29
    s_barrier
    buffer_load_dwordx4 v[24:27], v1, s[52:55], 0 offen offset:0 nt
    buffer_load_dwordx4 v[28:31], v1, s[52:55], 0 offen offset:128 nt
    buffer_load_dwordx4 v[32:35], v1, s[52:55], 0 offen offset:256 nt
    buffer_load_dwordx4 v[36:39], v1, s[52:55], s44 offen offset:0 nt
    s_waitcnt vmcnt(3)
    buffer_load_dwordx4 v[40:43], v1, s[52:55], s44 offen offset:128 nt
    s_waitcnt vmcnt(3)
    buffer_load_dwordx4 v[44:47], v1, s[52:55], s44 offen offset:256 nt
    s_waitcnt vmcnt(3)
    buffer_load_dwordx4 v[48:51], v1, s[52:55], s45 offen offset:0 nt
    s_waitcnt vmcnt(3)
    buffer_load_dwordx4 v[52:55], v1, s[52:55], s45 offen offset:128 nt
    s_mov_b64 exec, 1
    ds_add_u32 v3, v12 offset:8
    s_mov_b64 exec, -1
    s_waitcnt vmcnt(3)
    buffer_load_dwordx4 v[56:59], v1, s[52:55], s45 offen offset:256 nt
    s_waitcnt vmcnt(3)
    buffer_load_dwordx4 v[60:63], v1, s[52:55], s46 offen offset:0 nt
    s_waitcnt vmcnt(3)
    buffer_load_dwordx4 v[64:67], v1, s[52:55], s46 offen offset:128 nt
    s_waitcnt vmcnt(3)
    buffer_load_dwordx4 v[68:71], v1, s[52:55], s46 offen offset:256 nt
    s_waitcnt vmcnt(3)
    buffer_load_dwordx4 v[72:75], v1, s[52:55], s47 offen offset:0 nt
    s_waitcnt vmcnt(3)
    buffer_load_dwordx4 v[76:79], v1, s[52:55], s47 offen offset:128 nt
    s_waitcnt vmcnt(3)
    buffer_load_dwordx4 v[80:83], v1, s[52:55], s47 offen offset:256 nt
    s_waitcnt vmcnt(3)
    buffer_load_dwordx4 v[84:87], v1, s[52:55], s48 offen offset:0 nt
    s_waitcnt vmcnt(3)
    buffer_load_dwordx4 v[88:91], v1, s[52:55], s48 offen offset:128 nt
    s_waitcnt vmcnt(3)
    buffer_load_dwordx4 v[92:95], v1, s[52:55], s48 offen offset:256 nt
    s_waitcnt vmcnt(3)
    buffer_load_dwordx4 v[96:99], v1, s[52:55], s49 offen offset:0 nt
    s_waitcnt vmcnt(3)
    buffer_load_dwordx4 v[100:103], v1, s[52:55], s49 offen offset:128 nt
    s_waitcnt vmcnt(3)
    buffer_load_dwordx4 v[104:107], v1, s[52:55], s49 offen offset:256 nt
    s_waitcnt vmcnt(3)
    buffer_load_dwordx4 v[108:111], v1, s[52:55], s50 offen offset:0 nt
    s_waitcnt vmcnt(3)
    buffer_load_dwordx4 v[112:115], v1, s[52:55], s50 offen offset:128 nt
    s_waitcnt vmcnt(3)
    buffer_load_dwordx4 v[116:119], v1, s[52:55], s50 offen offset:256 nt
    s_waitcnt vmcnt(3)
    buffer_load_dwordx4 v[120:123], v1, s[56:59], 0 offen offset:0 nt
    s_waitcnt vmcnt(3)
    buffer_load_dwordx4 v[124:127], v1, s[56:59], 0 offen offset:128 nt
    s_waitcnt vmcnt(3)
    buffer_load_dwordx4 v[128:131], v1, s[56:59], 0 offen offset:256 nt
    s_waitcnt vmcnt(3)
    buffer_load_dwordx4 v[132:135], v1, s[56:59], s44 offen offset:0 nt
    s_waitcnt vmcnt(3)
    buffer_load_dwordx4 v[136:139], v1, s[56:59], s44 offen offset:128 nt
    s_waitcnt vmcnt(3)
    buffer_load_dwordx4 v[140:143], v1, s[56:59], s44 offen offset:256 nt
    s_waitcnt vmcnt(3)
    buffer_load_dwordx4 v[144:147], v1, s[56:59], s45 offen offset:0 nt
    s_waitcnt vmcnt(3)
    buffer_load_dwordx4 v[148:151], v1, s[56:59], s45 offen offset:128 nt
    s_waitcnt vmcnt(3)
    buffer_load_dwordx4 v[152:155], v1, s[56:59], s45 offen offset:256 nt
    s_waitcnt vmcnt(3)
    buffer_load_dwordx4 v[156:159], v1, s[56:59], s46 offen offset:0 nt
    s_waitcnt vmcnt(3)
    buffer_load_dwordx4 v[160:163], v1, s[56:59], s46 offen offset:128 nt
    s_waitcnt vmcnt(3)
    buffer_load_dwordx4 v[164:167], v1, s[56:59], s46 offen offset:256 nt
L_kv_qwait:
    ds_read_b32 v3, v3 offset:4
    ds_read_b128 v[12:15], v2 offset:64
    ds_read_b128 v[16:19], v2 offset:192
    ds_read_b128 v[20:23], v2 offset:320
    s_waitcnt lgkmcnt(0)
    v_readfirstlane_b32 s39, v3
    v_mov_b32 v3, 0
    s_cmp_lg_u32 s39, 0
    s_cbranch_scc1 L_kv_qready
    s_sleep 4
    s_branch L_kv_qwait
L_kv_qready:
    s_waitcnt vmcnt(24)
    v_dot2c_f32_bf16 v4, v24, v12
    v_dot2c_f32_bf16 v5, v36, v12
    v_dot2c_f32_bf16 v6, v48, v12
    v_dot2c_f32_bf16 v7, v60, v12
    v_dot2c_f32_bf16 v4, v25, v13
    v_dot2c_f32_bf16 v5, v37, v13
    v_dot2c_f32_bf16 v6, v49, v13
    v_dot2c_f32_bf16 v7, v61, v13
    v_dot2c_f32_bf16 v4, v26, v14
    v_dot2c_f32_bf16 v5, v38, v14
    v_dot2c_f32_bf16 v6, v50, v14
    v_dot2c_f32_bf16 v7, v62, v14
    v_dot2c_f32_bf16 v4, v27, v15
    v_dot2c_f32_bf16 v5, v39, v15
    v_dot2c_f32_bf16 v6, v51, v15
    v_dot2c_f32_bf16 v7, v63, v15
    v_dot2c_f32_bf16 v4, v28, v16
    v_dot2c_f32_bf16 v5, v40, v16
    v_dot2c_f32_bf16 v6, v52, v16
    v_dot2c_f32_bf16 v7, v64, v16
    v_dot2c_f32_bf16 v4, v29, v17
    v_dot2c_f32_bf16 v5, v41, v17
    v_dot2c_f32_bf16 v6, v53, v17
    v_dot2c_f32_bf16 v7, v65, v17
    v_dot2c_f32_bf16 v4, v30, v18
    v_dot2c_f32_bf16 v5, v42, v18
    v_dot2c_f32_bf16 v6, v54, v18
    v_dot2c_f32_bf16 v7, v66, v18
    v_dot2c_f32_bf16 v4, v31, v19
    v_dot2c_f32_bf16 v5, v43, v19
    v_dot2c_f32_bf16 v6, v55, v19
    v_dot2c_f32_bf16 v7, v67, v19
    v_dot2c_f32_bf16 v4, v32, v20
    v_dot2c_f32_bf16 v5, v44, v20
    v_dot2c_f32_bf16 v6, v56, v20
    v_dot2c_f32_bf16 v7, v68, v20
    v_dot2c_f32_bf16 v4, v33, v21
    v_dot2c_f32_bf16 v5, v45, v21
    v_dot2c_f32_bf16 v6, v57, v21
    v_dot2c_f32_bf16 v7, v69, v21
    v_dot2c_f32_bf16 v4, v34, v22
    v_dot2c_f32_bf16 v5, v46, v22
    v_dot2c_f32_bf16 v6, v58, v22
    v_dot2c_f32_bf16 v7, v70, v22
    v_dot2c_f32_bf16 v4, v35, v23
    v_dot2c_f32_bf16 v5, v47, v23
    v_dot2c_f32_bf16 v6, v59, v23
    v_dot2c_f32_bf16 v7, v71, v23
    s_waitcnt vmcnt(3)
    buffer_load_dwordx4 v[24:27], v1, s[56:59], s47 offen offset:0 nt
    s_waitcnt vmcnt(3)
    buffer_load_dwordx4 v[28:31], v1, s[56:59], s47 offen offset:128 nt
    s_waitcnt vmcnt(3)
    buffer_load_dwordx4 v[32:35], v1, s[56:59], s47 offen offset:256 nt
    v_add_f32_dpp v4, v4, v4 quad_perm:[1,0,3,2] row_mask:0xf bank_mask:0xf
    v_add_f32_dpp v5, v5, v5 quad_perm:[1,0,3,2] row_mask:0xf bank_mask:0xf
    v_add_f32_dpp v6, v6, v6 quad_perm:[1,0,3,2] row_mask:0xf bank_mask:0xf
    v_add_f32_dpp v7, v7, v7 quad_perm:[1,0,3,2] row_mask:0xf bank_mask:0xf
    v_add_f32_dpp v4, v4, v4 quad_perm:[2,3,0,1] row_mask:0xf bank_mask:0xf
    v_add_f32_dpp v5, v5, v5 quad_perm:[2,3,0,1] row_mask:0xf bank_mask:0xf
    v_add_f32_dpp v6, v6, v6 quad_perm:[2,3,0,1] row_mask:0xf bank_mask:0xf
    v_add_f32_dpp v7, v7, v7 quad_perm:[2,3,0,1] row_mask:0xf bank_mask:0xf
    v_add_f32_dpp v4, v4, v4 row_half_mirror row_mask:0xf bank_mask:0xf
    v_add_f32_dpp v5, v5, v5 row_half_mirror row_mask:0xf bank_mask:0xf
    v_add_f32_dpp v6, v6, v6 row_half_mirror row_mask:0xf bank_mask:0xf
    v_add_f32_dpp v7, v7, v7 row_half_mirror row_mask:0xf bank_mask:0xf
    s_waitcnt vmcnt(15)
    v_dot2c_f32_bf16 v8, v72, v12
    v_dot2c_f32_bf16 v9, v84, v12
    v_dot2c_f32_bf16 v10, v96, v12
    v_dot2c_f32_bf16 v11, v108, v12
    v_dot2c_f32_bf16 v8, v73, v13
    v_dot2c_f32_bf16 v9, v85, v13
    v_dot2c_f32_bf16 v10, v97, v13
    v_dot2c_f32_bf16 v11, v109, v13
    v_dot2c_f32_bf16 v8, v74, v14
    v_dot2c_f32_bf16 v9, v86, v14
    v_dot2c_f32_bf16 v10, v98, v14
    v_dot2c_f32_bf16 v11, v110, v14
    v_dot2c_f32_bf16 v8, v75, v15
    v_dot2c_f32_bf16 v9, v87, v15
    v_dot2c_f32_bf16 v10, v99, v15
    v_dot2c_f32_bf16 v11, v111, v15
    v_dot2c_f32_bf16 v8, v76, v16
    v_dot2c_f32_bf16 v9, v88, v16
    v_dot2c_f32_bf16 v10, v100, v16
    v_dot2c_f32_bf16 v11, v112, v16
    v_dot2c_f32_bf16 v8, v77, v17
    v_dot2c_f32_bf16 v9, v89, v17
    v_dot2c_f32_bf16 v10, v101, v17
    v_dot2c_f32_bf16 v11, v113, v17
    s_waitcnt vmcnt(3)
    buffer_load_dwordx4 v[36:39], v1, s[56:59], s48 offen offset:0 nt
    s_waitcnt vmcnt(3)
    buffer_load_dwordx4 v[40:43], v1, s[56:59], s48 offen offset:128 nt
    s_waitcnt vmcnt(3)
    buffer_load_dwordx4 v[44:47], v1, s[56:59], s48 offen offset:256 nt
    v_dot2c_f32_bf16 v8, v78, v18
    v_dot2c_f32_bf16 v9, v90, v18
    v_dot2c_f32_bf16 v10, v102, v18
    v_dot2c_f32_bf16 v11, v114, v18
    v_dot2c_f32_bf16 v8, v79, v19
    v_dot2c_f32_bf16 v9, v91, v19
    v_dot2c_f32_bf16 v10, v103, v19
    v_dot2c_f32_bf16 v11, v115, v19
    v_dot2c_f32_bf16 v8, v80, v20
    v_dot2c_f32_bf16 v9, v92, v20
    v_dot2c_f32_bf16 v10, v104, v20
    v_dot2c_f32_bf16 v11, v116, v20
    v_dot2c_f32_bf16 v8, v81, v21
    v_dot2c_f32_bf16 v9, v93, v21
    v_dot2c_f32_bf16 v10, v105, v21
    v_dot2c_f32_bf16 v11, v117, v21
    v_dot2c_f32_bf16 v8, v82, v22
    v_dot2c_f32_bf16 v9, v94, v22
    v_dot2c_f32_bf16 v10, v106, v22
    v_dot2c_f32_bf16 v11, v118, v22
    v_dot2c_f32_bf16 v8, v83, v23
    v_dot2c_f32_bf16 v9, v95, v23
    v_dot2c_f32_bf16 v10, v107, v23
    v_dot2c_f32_bf16 v11, v119, v23
    v_add_f32_dpp v8, v8, v8 quad_perm:[1,0,3,2] row_mask:0xf bank_mask:0xf
    v_add_f32_dpp v9, v9, v9 quad_perm:[1,0,3,2] row_mask:0xf bank_mask:0xf
    v_add_f32_dpp v10, v10, v10 quad_perm:[1,0,3,2] row_mask:0xf bank_mask:0xf
    v_add_f32_dpp v11, v11, v11 quad_perm:[1,0,3,2] row_mask:0xf bank_mask:0xf
    v_add_f32_dpp v8, v8, v8 quad_perm:[2,3,0,1] row_mask:0xf bank_mask:0xf
    v_add_f32_dpp v9, v9, v9 quad_perm:[2,3,0,1] row_mask:0xf bank_mask:0xf
    v_add_f32_dpp v10, v10, v10 quad_perm:[2,3,0,1] row_mask:0xf bank_mask:0xf
    v_add_f32_dpp v11, v11, v11 quad_perm:[2,3,0,1] row_mask:0xf bank_mask:0xf
    v_add_f32_dpp v8, v8, v8 row_half_mirror row_mask:0xf bank_mask:0xf
    v_add_f32_dpp v9, v9, v9 row_half_mirror row_mask:0xf bank_mask:0xf
    v_add_f32_dpp v10, v10, v10 row_half_mirror row_mask:0xf bank_mask:0xf
    v_add_f32_dpp v11, v11, v11 row_half_mirror row_mask:0xf bank_mask:0xf
    s_waitcnt vmcnt(3)
    buffer_load_dwordx4 v[48:51], v1, s[56:59], s49 offen offset:0 nt
    v_max3_f32 v12, v4, v5, v6
    v_max3_f32 v13, v7, v8, v9
    v_max3_f32 v12, v12, v10, v11
    v_max_f32 v12, v12, v13
    s_lshl_b32 s30, s18, 3
    v_mov_b32 v17, s30
    v_max_f32_dpp v12, v12, v12 row_ror:8 row_mask:0xf bank_mask:0xf
    s_mov_b32 s36, 0
    s_brev_b32 s37, 1
    v_max_f32_dpp v12, v12, v12 row_bcast:15 row_mask:0xa bank_mask:0xf
    v_and_b32 v16, 7, v0
    s_nop 0
    v_max_f32_dpp v12, v12, v12 row_bcast:31 row_mask:0xc bank_mask:0xf
    s_nop 0
    v_readlane_b32 s38, v12, 63
    v_and_b32 v14, 1, v0
    v_lshlrev_b32 v14, 4, v14
    v_mov_b32 v15, 0xffff
    v_lshlrev_b32 v14, v14, v15
    s_mov_b32 s20, 0x03030303
    s_mov_b32 s21, 0x03030303
    v_cndmask_b32 v116, 0, v14, s[20:21]
    s_lshl_b64 s[20:21], s[20:21], 2
    v_cndmask_b32 v117, 0, v14, s[20:21]
    s_lshl_b64 s[20:21], s[20:21], 2
    v_cndmask_b32 v118, 0, v14, s[20:21]
    s_lshl_b64 s[20:21], s[20:21], 2
    v_cndmask_b32 v119, 0, v14, s[20:21]
    v_mov_b32 v18, s38
    v_mul_f32 v12, s19, v18
    v_fma_f32 v4, v4, s19, -v12
    v_fma_f32 v5, v5, s19, -v12
    v_fma_f32 v6, v6, s19, -v12
    v_fma_f32 v7, v7, s19, -v12
    v_fma_f32 v8, v8, s19, -v12
    v_fma_f32 v9, v9, s19, -v12
    v_fma_f32 v10, v10, s19, -v12
    v_fma_f32 v11, v11, s19, -v12
    v_exp_f32 v4, v4
    v_exp_f32 v5, v5
    v_exp_f32 v6, v6
    v_exp_f32 v7, v7
    v_exp_f32 v8, v8
    v_exp_f32 v9, v9
    v_exp_f32 v10, v10
    v_exp_f32 v11, v11
    s_waitcnt vmcnt(3)
    buffer_load_dwordx4 v[52:55], v1, s[56:59], s49 offen offset:128 nt
    v_add_f32 v12, v4, v5
    v_add_f32 v13, v6, v7
    v_add_f32 v14, v8, v9
    v_add_f32 v15, v10, v11
    v_add_f32 v12, v12, v13
    v_add_f32 v14, v14, v15
    v_add_f32 v19, v12, v14
    v_cvt_pk_bf16_f32 v4, v4, v4
    v_cvt_pk_bf16_f32 v5, v5, v5
    v_add_f32_dpp v19, v19, v19 row_ror:8 row_mask:0xf bank_mask:0xf
    v_cvt_pk_bf16_f32 v6, v6, v6
    v_cvt_pk_bf16_f32 v7, v7, v7
    v_add_f32_dpp v19, v19, v19 row_bcast:15 row_mask:0xa bank_mask:0xf
    v_cvt_pk_bf16_f32 v8, v8, v8
    v_cvt_pk_bf16_f32 v9, v9, v9
    v_add_f32_dpp v19, v19, v19 row_bcast:31 row_mask:0xc bank_mask:0xf
    v_cvt_pk_bf16_f32 v10, v10, v10
    v_cvt_pk_bf16_f32 v11, v11, v11
    s_mov_b64 exec, s[36:37]
    ds_write_b64 v17, v[18:19] offset:480
    s_mov_b64 exec, -1
    s_waitcnt vmcnt(3)
    buffer_load_dwordx4 v[56:59], v1, s[56:59], s49 offen offset:256 nt
    v_and_b32 v72, v116, v4
    v_and_b32 v73, v117, v4
    v_and_b32 v74, v118, v4
    v_and_b32 v75, v119, v4
    v_and_b32 v76, v116, v5
    v_and_b32 v77, v117, v5
    v_and_b32 v78, v118, v5
    v_and_b32 v79, v119, v5
    v_and_b32 v80, v116, v6
    v_and_b32 v81, v117, v6
    v_and_b32 v82, v118, v6
    v_and_b32 v83, v119, v6
    v_and_b32 v84, v116, v7
    v_and_b32 v85, v117, v7
    v_and_b32 v86, v118, v7
    v_and_b32 v87, v119, v7
    s_waitcnt vmcnt(9)
    v_mfma_f32_16x16x32_bf16 v[104:107], v[72:75], v[120:123], 0
    v_mfma_f32_16x16x32_bf16 v[108:111], v[72:75], v[124:127], 0
    v_mfma_f32_16x16x32_bf16 v[112:115], v[72:75], v[128:131], 0
    v_mfma_f32_16x16x32_bf16 v[104:107], v[76:79], v[132:135], v[104:107]
    v_mfma_f32_16x16x32_bf16 v[108:111], v[76:79], v[136:139], v[108:111]
    v_mfma_f32_16x16x32_bf16 v[112:115], v[76:79], v[140:143], v[112:115]
    v_mfma_f32_16x16x32_bf16 v[104:107], v[80:83], v[144:147], v[104:107]
    v_mfma_f32_16x16x32_bf16 v[108:111], v[80:83], v[148:151], v[108:111]
    v_mfma_f32_16x16x32_bf16 v[112:115], v[80:83], v[152:155], v[112:115]
    v_mfma_f32_16x16x32_bf16 v[104:107], v[84:87], v[156:159], v[104:107]
    v_mfma_f32_16x16x32_bf16 v[108:111], v[84:87], v[160:163], v[108:111]
    v_mfma_f32_16x16x32_bf16 v[112:115], v[84:87], v[164:167], v[112:115]
    s_waitcnt vmcnt(3)
    buffer_load_dwordx4 v[60:63], v1, s[56:59], s50 offen offset:0 nt
    v_and_b32 v88, v116, v8
    v_and_b32 v89, v117, v8
    v_and_b32 v90, v118, v8
    v_and_b32 v91, v119, v8
    v_and_b32 v92, v116, v9
    v_and_b32 v93, v117, v9
    v_and_b32 v94, v118, v9
    v_and_b32 v95, v119, v9
    v_and_b32 v96, v116, v10
    v_and_b32 v97, v117, v10
    v_and_b32 v98, v118, v10
    v_and_b32 v99, v119, v10
    v_and_b32 v100, v116, v11
    v_and_b32 v101, v117, v11
    v_and_b32 v102, v118, v11
    v_and_b32 v103, v119, v11
    s_waitcnt vmcnt(3)
    buffer_load_dwordx4 v[64:67], v1, s[56:59], s50 offen offset:128 nt
    s_mul_i32 s41, s42, 0x9e3779b1
    s_add_u32 s41, s41, 0x7f4a7c15
    s_and_b32 s41, s41, 0xbfffbfff
    s_xor_b32 s20, s41, 0x100
    s_xor_b32 s21, s41, s42
    s_cmp_lt_u32 s21, 16
    s_cselect_b32 s41, s20, s41
    v_lshlrev_b32 v2, 5, v16
    v_bfe_u32 v14, v0, 4, 1
    v_lshl_add_u32 v2, v14, 4, v2
    v_lshrrev_b32 v14, 5, v0
    s_lshl_b32 s30, s18, 1
    s_sub_u32 s30, s30, 8
    v_add_u32 v14, s30, v14
    v_mul_u32_u24 v14, 768, v14
    v_add_u32 v2, v2, v14
    v_lshrrev_b32 v6, 2, v0
    v_mul_u32_u24 v7, 24, v6
    v_and_b32 v4, 3, v0
    v_min_u32 v15, 2, v4
    v_lshl_add_u32 v20, v15, 3, v7
    v_mul_u32_u24 v4, 640, v4
    v_lshl_add_u32 v5, v6, 4, v4
    v_lshlrev_b32 v21, 3, v16
    v_lshlrev_b32 v22, 2, v0
    v_mov_b32 v14, s41
    v_mov_b32 v15, s41
    v_mov_b32 v17, 16
    v_mov_b32 v23, 1
    s_mul_i32 s26, s4, 2560
    s_add_u32 s26, s26, 135168
    s_mul_i32 s30, s5, 640
    s_add_u32 s30, s30, s26
    s_and_b32 s27, s5, 1
    s_lshl_b32 s27, s27, 8
    s_add_u32 s27, s27, s26
    s_mov_b32 s20, 0x11111111
    s_mov_b32 s21, 0x11111111
    s_mov_b32 s43, 32768
    s_waitcnt vmcnt(3)
    buffer_load_dwordx4 v[68:71], v1, s[56:59], s50 offen offset:256 nt
    s_mov_b64 exec, 1
    ds_add_u32 v3, v17 offset:8
    s_mov_b64 exec, -1
    s_waitcnt vmcnt(9)
    v_mfma_f32_16x16x32_bf16 v[104:107], v[88:91], v[24:27], v[104:107]
    v_mfma_f32_16x16x32_bf16 v[108:111], v[88:91], v[28:31], v[108:111]
    v_mfma_f32_16x16x32_bf16 v[112:115], v[88:91], v[32:35], v[112:115]
    s_waitcnt vmcnt(6)
    v_mfma_f32_16x16x32_bf16 v[104:107], v[92:95], v[36:39], v[104:107]
    v_mfma_f32_16x16x32_bf16 v[108:111], v[92:95], v[40:43], v[108:111]
    v_mfma_f32_16x16x32_bf16 v[112:115], v[92:95], v[44:47], v[112:115]
    s_waitcnt vmcnt(3)
    v_mfma_f32_16x16x32_bf16 v[104:107], v[96:99], v[48:51], v[104:107]
    v_mfma_f32_16x16x32_bf16 v[108:111], v[96:99], v[52:55], v[108:111]
    v_mfma_f32_16x16x32_bf16 v[112:115], v[96:99], v[56:59], v[112:115]
    s_waitcnt vmcnt(0)
    v_mfma_f32_16x16x32_bf16 v[104:107], v[100:103], v[60:63], v[104:107]
    v_mfma_f32_16x16x32_bf16 v[108:111], v[100:103], v[64:67], v[108:111]
    v_mfma_f32_16x16x32_bf16 v[112:115], v[100:103], v[68:71], v[112:115]
    s_setprio 3
    s_nop 5
    s_mov_b64 exec, s[34:35]
    ds_write_b128 v2, v[104:107] offset:7168
    ds_write_b128 v2, v[108:111] offset:7424
    ds_write_b128 v2, v[112:115] offset:7680
    s_mov_b64 exec, 1
    ds_add_rtn_u32 v24, v3, v23 offset:12
    s_mov_b64 exec, -1
    s_waitcnt lgkmcnt(0)
    v_readfirstlane_b32 s22, v24
    s_cmp_lt_u32 s22, 5
    s_cbranch_scc1 L_kv_end
    s_cmp_eq_u32 s22, 7
    s_cbranch_scc1 L_kv_oall
L_kv_owait:
    ds_read_b32 v24, v3 offset:12
    s_waitcnt lgkmcnt(0)
    v_readfirstlane_b32 s23, v24
    s_cmp_ge_u32 s23, 8
    s_cbranch_scc0 L_kv_owait
L_kv_oall:
    ds_read_b64 v[18:19], v21 offset:512
    s_sub_u32 s22, 7, s22
    s_lshl_b32 s23, s22, 8
    s_add_u32 s30, s30, s23
    s_cmp_eq_u32 s22, 2
    s_cbranch_scc1 L_kv_ml
    s_mul_i32 s23, s22, 384
    v_add_u32 v20, s23, v20
    ds_read_b64 v[24:25], v20 offset:7168
    ds_read_b64 v[26:27], v20 offset:7936
    ds_read_b64 v[28:29], v20 offset:8704
    ds_read_b64 v[30:31], v20 offset:9472
    ds_read_b64 v[32:33], v20 offset:10240
    ds_read_b64 v[34:35], v20 offset:11008
    ds_read_b64 v[36:37], v20 offset:11776
    ds_read_b64 v[38:39], v20 offset:12544
    ds_read_b64 v[40:41], v20 offset:13312
    ds_read_b64 v[42:43], v20 offset:14080
    ds_read_b64 v[44:45], v20 offset:14848
    ds_read_b64 v[46:47], v20 offset:15616
    ds_read_b64 v[48:49], v20 offset:16384
    ds_read_b64 v[50:51], v20 offset:17152
    s_waitcnt lgkmcnt(12)
    ds_read_b64 v[52:53], v20 offset:17920
    ds_read_b64 v[54:55], v20 offset:18688
    v_max_f32_dpp v12, v18, v18 quad_perm:[1,0,3,2] row_mask:0xf bank_mask:0xf
    s_nop 1
    v_max_f32_dpp v12, v12, v12 quad_perm:[2,3,0,1] row_mask:0xf bank_mask:0xf
    s_nop 1
    v_max_f32_dpp v12, v12, v12 row_half_mirror row_mask:0xf bank_mask:0xf
    v_sub_f32 v13, v18, v12
    v_mul_f32 v13, s19, v13
    v_exp_f32 v13, v13
    s_waitcnt lgkmcnt(14)
    v_add_f32 v24, v24, v26
    v_add_f32 v25, v25, v27
    v_mul_f32_dpp v56, v13, v24 row_newbcast:0 row_mask:0xf bank_mask:0xf
    v_mul_f32_dpp v57, v13, v25 row_newbcast:0 row_mask:0xf bank_mask:0xf
    s_waitcnt lgkmcnt(12)
    v_add_f32 v28, v28, v30
    v_add_f32 v29, v29, v31
    v_fmac_f32_dpp v56, v13, v28 row_newbcast:1 row_mask:0xf bank_mask:0xf
    v_fmac_f32_dpp v57, v13, v29 row_newbcast:1 row_mask:0xf bank_mask:0xf
    s_waitcnt lgkmcnt(10)
    v_add_f32 v32, v32, v34
    v_add_f32 v33, v33, v35
    v_fmac_f32_dpp v56, v13, v32 row_newbcast:2 row_mask:0xf bank_mask:0xf
    v_fmac_f32_dpp v57, v13, v33 row_newbcast:2 row_mask:0xf bank_mask:0xf
    s_waitcnt lgkmcnt(8)
    v_add_f32 v36, v36, v38
    v_add_f32 v37, v37, v39
    v_fmac_f32_dpp v56, v13, v36 row_newbcast:3 row_mask:0xf bank_mask:0xf
    v_fmac_f32_dpp v57, v13, v37 row_newbcast:3 row_mask:0xf bank_mask:0xf
    s_waitcnt lgkmcnt(6)
    v_add_f32 v40, v40, v42
    v_add_f32 v41, v41, v43
    v_fmac_f32_dpp v56, v13, v40 row_newbcast:4 row_mask:0xf bank_mask:0xf
    v_fmac_f32_dpp v57, v13, v41 row_newbcast:4 row_mask:0xf bank_mask:0xf
    s_waitcnt lgkmcnt(4)
    v_add_f32 v44, v44, v46
    v_add_f32 v45, v45, v47
    v_fmac_f32_dpp v56, v13, v44 row_newbcast:5 row_mask:0xf bank_mask:0xf
    v_fmac_f32_dpp v57, v13, v45 row_newbcast:5 row_mask:0xf bank_mask:0xf
    s_waitcnt lgkmcnt(2)
    v_add_f32 v48, v48, v50
    v_add_f32 v49, v49, v51
    v_fmac_f32_dpp v56, v13, v48 row_newbcast:6 row_mask:0xf bank_mask:0xf
    v_fmac_f32_dpp v57, v13, v49 row_newbcast:6 row_mask:0xf bank_mask:0xf
    s_waitcnt lgkmcnt(0)
    v_add_f32 v52, v52, v54
    v_add_f32 v53, v53, v55
    v_fmac_f32_dpp v56, v13, v52 row_newbcast:7 row_mask:0xf bank_mask:0xf
    v_fmac_f32_dpp v57, v13, v53 row_newbcast:7 row_mask:0xf bank_mask:0xf
    v_cvt_pk_bf16_f32 v56, v56, v57
    v_mov_b32 v59, v14
    s_cmp_eq_u32 s39, 2
    v_mov_b32_dpp v57, v56 quad_perm:[1,1,1,1] row_mask:0xf bank_mask:0xf
    v_mov_b32_dpp v58, v56 quad_perm:[2,2,2,2] row_mask:0xf bank_mask:0xf
    s_mov_b64 exec, s[20:21]
    s_cbranch_scc1 L_kv_pubfast
    buffer_store_dwordx4 v[56:59], v22, s[68:71], s30 offen sc1
    s_branch L_kv_pubdone
L_kv_pubfast:
    buffer_store_dwordx4 v[56:59], v22, s[68:71], s30 offen
L_kv_pubdone:
    s_mov_b64 exec, 1
    ds_add_u32 v3, v23 offset:12
    s_branch L_kv_end
L_kv_ml:
    v_lshlrev_b32 v22, 4, v0
    s_waitcnt lgkmcnt(0)
    v_max_f32_dpp v12, v18, v18 quad_perm:[1,0,3,2] row_mask:0xf bank_mask:0xf
    s_nop 1
    v_max_f32_dpp v12, v12, v12 quad_perm:[2,3,0,1] row_mask:0xf bank_mask:0xf
    s_nop 1
    v_max_f32_dpp v12, v12, v12 row_half_mirror row_mask:0xf bank_mask:0xf
    v_sub_f32 v13, v18, v12
    v_mul_f32 v13, s19, v13
    v_exp_f32 v13, v13
    s_nop 0
    v_mul_f32 v13, v13, v19
    s_nop 1
    v_add_f32_dpp v13, v13, v13 quad_perm:[1,0,3,2] row_mask:0xf bank_mask:0xf
    s_nop 1
    v_add_f32_dpp v13, v13, v13 quad_perm:[2,3,0,1] row_mask:0xf bank_mask:0xf
    s_cmp_eq_u32 s39, 2
    s_nop 0
    v_add_f32_dpp v13, v13, v13 row_half_mirror row_mask:0xf bank_mask:0xf
    s_mov_b64 exec, 0xff
    s_cbranch_scc1 L_kv_mlfast
    buffer_store_dwordx4 v[12:15], v22, s[68:71], s30 offen sc1
    s_mov_b64 exec, -1
    s_sleep 16
L_kv_opoll:
    buffer_load_dwordx4 v[28:31], v5, s[68:71], s27 offen sc1
    buffer_load_dwordx4 v[32:35], v4, s[68:71], s26 offen offset:512 sc1
    s_sub_u32 s43, s43, 1
    s_cbranch_scc1 L_kv_g0
    s_waitcnt vmcnt(0)
    v_cmp_ne_u32 vcc, s41, v31
    v_cmp_ne_u32 s[22:23], s41, v35
    s_or_b64 vcc, vcc, s[22:23]
    s_cbranch_scc1 L_kv_opoll
    s_branch L_kv_g0
L_kv_mlfast:
    buffer_store_dwordx4 v[12:15], v22, s[68:71], s30 offen
    s_mov_b64 exec, -1
L_kv_pwait:
    ds_read_b32 v27, v3 offset:12
    s_waitcnt lgkmcnt(0)
    v_readfirstlane_b32 s23, v27
    s_cmp_ge_u32 s23, 10
    s_cbranch_scc0 L_kv_pwait
    buffer_load_dwordx4 v[28:31], v5, s[68:71], s27 offen sc1 nt
    buffer_load_dwordx4 v[32:35], v4, s[68:71], s26 offen offset:512 sc1 nt
    s_sleep 4
    buffer_load_dwordx4 v[48:51], v5, s[68:71], s27 offen sc1 nt
    buffer_load_dwordx4 v[52:55], v4, s[68:71], s26 offen offset:512 sc1 nt
    s_sleep 4
    buffer_load_dwordx4 v[56:59], v5, s[68:71], s27 offen sc1 nt
    buffer_load_dwordx4 v[60:63], v4, s[68:71], s26 offen offset:512 sc1 nt
    s_sleep 4
L_kv_gp:
    buffer_load_dwordx4 v[64:67], v5, s[68:71], s27 offen sc1 nt
    buffer_load_dwordx4 v[68:71], v4, s[68:71], s26 offen offset:512 sc1 nt
    s_waitcnt vmcnt(6)
    v_cmp_ne_u32 vcc, s41, v31
    v_cmp_ne_u32 s[22:23], s41, v35
    s_or_b64 vcc, vcc, s[22:23]
    s_cbranch_scc0 L_kv_g0
    buffer_load_dwordx4 v[28:31], v5, s[68:71], s27 offen sc1 nt
    buffer_load_dwordx4 v[32:35], v4, s[68:71], s26 offen offset:512 sc1 nt
    s_waitcnt vmcnt(6)
    v_cmp_ne_u32 vcc, s41, v51
    v_cmp_ne_u32 s[22:23], s41, v55
    s_or_b64 vcc, vcc, s[22:23]
    s_cbranch_scc0 L_kv_g1
    buffer_load_dwordx4 v[48:51], v5, s[68:71], s27 offen sc1 nt
    buffer_load_dwordx4 v[52:55], v4, s[68:71], s26 offen offset:512 sc1 nt
    s_waitcnt vmcnt(6)
    v_cmp_ne_u32 vcc, s41, v59
    v_cmp_ne_u32 s[22:23], s41, v63
    s_or_b64 vcc, vcc, s[22:23]
    s_cbranch_scc0 L_kv_g2
    buffer_load_dwordx4 v[56:59], v5, s[68:71], s27 offen sc1 nt
    buffer_load_dwordx4 v[60:63], v4, s[68:71], s26 offen offset:512 sc1 nt
    s_waitcnt vmcnt(6)
    v_cmp_ne_u32 vcc, s41, v67
    v_cmp_ne_u32 s[22:23], s41, v71
    s_or_b64 vcc, vcc, s[22:23]
    s_cbranch_scc0 L_kv_g3
    s_sub_u32 s43, s43, 1
    s_cbranch_scc0 L_kv_gp
L_kv_g3:
    v_mov_b32 v76, v68
    v_mov_b32 v72, v64
    v_mov_b32 v73, v65
    v_mov_b32 v74, v66
    v_mov_b32 v77, v69
    s_branch L_kv_comb
L_kv_g2:
    v_mov_b32 v76, v60
    v_mov_b32 v72, v56
    v_mov_b32 v73, v57
    v_mov_b32 v74, v58
    v_mov_b32 v77, v61
    s_branch L_kv_comb
L_kv_g1:
    v_mov_b32 v76, v52
    v_mov_b32 v72, v48
    v_mov_b32 v73, v49
    v_mov_b32 v74, v50
    v_mov_b32 v77, v53
    s_branch L_kv_comb
L_kv_g0:
    v_mov_b32 v76, v32
    v_mov_b32 v72, v28
    v_mov_b32 v73, v29
    v_mov_b32 v74, v30
    v_mov_b32 v77, v33
L_kv_comb:
    v_max_f32_dpp v36, v76, v76 quad_perm:[1,0,3,2] row_mask:0xf bank_mask:0xf
    v_lshlrev_b32 v40, 16, v72
    v_and_b32 v41, 0xffff0000, v72
    v_max_f32_dpp v36, v36, v36 quad_perm:[2,3,0,1] row_mask:0xf bank_mask:0xf
    v_lshlrev_b32 v42, 16, v73
    v_sub_f32 v36, v76, v36
    v_mul_f32 v36, s19, v36
    v_exp_f32 v36, v36
    v_and_b32 v43, 0xffff0000, v73
    v_mul_f32 v37, v36, v77
    v_lshlrev_b32 v44, 16, v74
    v_and_b32 v45, 0xffff0000, v74
    v_add_f32_dpp v37, v37, v37 quad_perm:[1,0,3,2] row_mask:0xf bank_mask:0xf
    v_mul_f32 v40, v36, v40
    v_mul_f32 v41, v36, v41
    v_add_f32_dpp v37, v37, v37 quad_perm:[2,3,0,1] row_mask:0xf bank_mask:0xf
    v_mul_f32 v42, v36, v42
    v_mul_f32 v43, v36, v43
    v_mul_f32 v44, v36, v44
    v_mul_f32 v45, v36, v45
    v_rcp_f32 v37, v37
    v_add_f32_dpp v40, v40, v40 quad_perm:[1,0,3,2] row_mask:0xf bank_mask:0xf
    v_add_f32_dpp v41, v41, v41 quad_perm:[1,0,3,2] row_mask:0xf bank_mask:0xf
    v_add_f32_dpp v42, v42, v42 quad_perm:[1,0,3,2] row_mask:0xf bank_mask:0xf
    v_add_f32_dpp v43, v43, v43 quad_perm:[1,0,3,2] row_mask:0xf bank_mask:0xf
    v_add_f32_dpp v44, v44, v44 quad_perm:[1,0,3,2] row_mask:0xf bank_mask:0xf
    v_add_f32_dpp v45, v45, v45 quad_perm:[1,0,3,2] row_mask:0xf bank_mask:0xf
    v_add_f32_dpp v40, v40, v40 quad_perm:[2,3,0,1] row_mask:0xf bank_mask:0xf
    v_add_f32_dpp v41, v41, v41 quad_perm:[2,3,0,1] row_mask:0xf bank_mask:0xf
    v_add_f32_dpp v42, v42, v42 quad_perm:[2,3,0,1] row_mask:0xf bank_mask:0xf
    v_add_f32_dpp v43, v43, v43 quad_perm:[2,3,0,1] row_mask:0xf bank_mask:0xf
    v_add_f32_dpp v44, v44, v44 quad_perm:[2,3,0,1] row_mask:0xf bank_mask:0xf
    v_add_f32_dpp v45, v45, v45 quad_perm:[2,3,0,1] row_mask:0xf bank_mask:0xf
    v_mul_f32 v40, v37, v40
    v_mul_f32 v41, v37, v41
    v_mul_f32 v42, v37, v42
    v_mul_f32 v43, v37, v43
    v_mul_f32 v44, v37, v44
    v_mul_f32 v45, v37, v45
    v_cvt_pk_bf16_f32 v40, v40, v40
    v_cvt_pk_bf16_f32 v41, v41, v41
    v_cvt_pk_bf16_f32 v42, v42, v42
    v_cvt_pk_bf16_f32 v43, v43, v43
    v_cvt_pk_bf16_f32 v44, v44, v44
    v_cvt_pk_bf16_f32 v45, v45, v45
    s_mov_b64 exec, s[20:21]
    ds_write_b64 v7, v[40:41] offset:640
    ds_write_b64 v7, v[42:43] offset:648
    ds_write_b64 v7, v[44:45] offset:656
    s_mov_b64 exec, 1
    ds_write_b32 v3, v23 offset:16
L_kv_end:
    s_endpgm
.section .rodata,"a"
.p2align 6
.amdhsa_kernel concat_heads__sliding_block_cached__sliding_block_cached__decode_kernel
  .amdhsa_next_free_vgpr 168
  .amdhsa_next_free_sgpr 96
  .amdhsa_accum_offset 168
  .amdhsa_group_segment_fixed_size 0
  .amdhsa_kernarg_size 104
  .amdhsa_user_sgpr_count 2
  .amdhsa_user_sgpr_kernarg_segment_ptr 1
  .amdhsa_system_sgpr_workgroup_id_x 1
  .amdhsa_float_denorm_mode_32 3
.end_amdhsa_kernel
```
